```python
import torch

def _softmax(x, axis=-1):
    return torch.softmax(x, dim=axis)
def _gelu(x):
    return torch.nn.functional.gelu(x, approximate="tanh")
def _silu(x):
    return torch.nn.functional.silu(x)
def _sigmoid(x):
    return torch.sigmoid(x)
def _layernorm(x, axis=-1, eps=1e-5):
    m = x.mean(dim=axis, keepdim=True)
    v = x.var(dim=axis, keepdim=True, unbiased=False)
    return (x - m) / torch.sqrt(v + eps)
def _scatter_add(tgt, idx, src, axis=0):
    return tgt.clone().index_add_(axis, idx, src)
def _segment_sum(src, seg, n):
    out = torch.zeros((n,) + src.shape[1:], dtype=src.dtype)
    return out.index_add_(0, seg, src)
def _pad(x, pw):
    flat = tuple(v for pair in reversed(pw) for v in pair)
    return torch.nn.functional.pad(x, flat)

kernel_name = 'concat_heads__spectral_fnet__spectral_fnet__prompt'

def setup_inputs():

    _w = (lambda a: (lambda t: t.to(torch.bfloat16) if t.is_floating_point() else t)(torch.as_tensor(a)))
    def _A_setup():
        B, S, D = 1, 2048, 512
        ns = torch.arange(S)[:, None] * torch.arange(S)[None, :]
        nd = torch.arange(D)[:, None] * torch.arange(D)[None, :]
        Ws_re = torch.cos(-2.0 * torch.pi * ns / S).to(float)
        Ws_im = torch.sin(-2.0 * torch.pi * ns / S).to(float)
        Wd_re = torch.cos(-2.0 * torch.pi * nd / D).to(float)
        Wd_im = torch.sin(-2.0 * torch.pi * nd / D).to(float)
        return {
            "x": _w((lambda *s: torch.randn(*s, dtype=torch.bfloat16) * 0.05)(B, S, D)),
            "dft_seq_re": _w(Ws_re),
            "dft_seq_im": _w(Ws_im),
            "dft_hid_re": _w(Wd_re),
            "dft_hid_im": _w(Wd_im),
        }
    _A_in = _A_setup()

    def _B_setup():
        B, S, D = 1, 2048, 512
        ns = torch.arange(S)[:, None] * torch.arange(S)[None, :]
        nd = torch.arange(D)[:, None] * torch.arange(D)[None, :]
        Ws_re = torch.cos(-2.0 * torch.pi * ns / S).to(float)
        Ws_im = torch.sin(-2.0 * torch.pi * ns / S).to(float)
        Wd_re = torch.cos(-2.0 * torch.pi * nd / D).to(float)
        Wd_im = torch.sin(-2.0 * torch.pi * nd / D).to(float)
        return {
            "x": _w((lambda *s: torch.randn(*s, dtype=torch.bfloat16) * 0.05)(B, S, D)),
            "dft_seq_re": _w(Ws_re),
            "dft_seq_im": _w(Ws_im),
            "dft_hid_re": _w(Wd_re),
            "dft_hid_im": _w(Wd_im),
        }
    _B_in = _B_setup()

    return {
        "A_x": _A_in["x"],
        "A_dft_seq_re": _A_in["dft_seq_re"],
        "A_dft_seq_im": _A_in["dft_seq_im"],
        "A_dft_hid_re": _A_in["dft_hid_re"],
        "A_dft_hid_im": _A_in["dft_hid_im"],
        "B_x": _B_in["x"],
        "B_dft_seq_re": _B_in["dft_seq_re"],
        "B_dft_seq_im": _B_in["dft_seq_im"],
        "B_dft_hid_re": _B_in["dft_hid_re"],
        "B_dft_hid_im": _B_in["dft_hid_im"],
    }

def reference(A_x, A_dft_seq_re, A_dft_seq_im, A_dft_hid_re, A_dft_hid_im, B_x, B_dft_seq_re, B_dft_seq_im, B_dft_hid_re, B_dft_hid_im):
    def _A_ref(x, dft_seq_re, dft_seq_im, dft_hid_re, dft_hid_im):
        a = torch.einsum("bsd,ed->bse", x, dft_hid_re)
        b = torch.einsum("bsd,ed->bse", x, dft_hid_im)
        y = torch.einsum("ts,bse->bte", dft_seq_re, a) - torch.einsum("ts,bse->bte", dft_seq_im, b)
        return y

    def _B_ref(x, dft_seq_re, dft_seq_im, dft_hid_re, dft_hid_im):
        a = torch.einsum("bsd,ed->bse", x, dft_hid_re)
        b = torch.einsum("bsd,ed->bse", x, dft_hid_im)
        y = torch.einsum("ts,bse->bte", dft_seq_re, a) - torch.einsum("ts,bse->bte", dft_seq_im, b)
        return y

    a = _A_ref(A_x, A_dft_seq_re, A_dft_seq_im, A_dft_hid_re, A_dft_hid_im)
    b = _B_ref(B_x, B_dft_seq_re, B_dft_seq_im, B_dft_hid_re, B_dft_hid_im)
    return torch.concatenate([a, b], axis=-1)
```

```asm
; @launch grid=(258,1,1) block=(512,1,1) lds=47104
.amdgcn_target "amdgcn-amd-amdhsa--gfx950"
.text
.globl concat_heads__spectral_fnet__spectral_fnet__prompt_kernel
.p2align 8
.type concat_heads__spectral_fnet__spectral_fnet__prompt_kernel,@function
concat_heads__spectral_fnet__spectral_fnet__prompt_kernel:
    s_cmp_ge_u32 s2, 258
    s_cbranch_scc1 K_END
    s_load_dwordx2 s[4:5], s[0:1], 0
    s_load_dwordx2 s[6:7], s[0:1], 40
    s_load_dwordx2 s[8:9], s[0:1], 96
    s_load_dwordx2 s[56:57], s[0:1], 80
    v_lshrrev_b32 v1, 6, v0
    v_and_b32 v2, 63, v0
    s_nop 0
    v_readfirstlane_b32 s20, v1
    s_lshl_b32 s26, s20, 11
    s_cmp_ge_u32 s2, 256
    s_cbranch_scc1 SPECIAL_WG

    s_setprio 1
    s_and_b32 s21, s2, 7
    s_bfe_u32 s22, s2, 0x40003
    s_bfe_u32 s23, s2, 0x10007
    v_lshrrev_b32 v3, 2, v2
    v_lshlrev_b32 v3, 17, v3
    v_and_b32 v4, 3, v2
    v_lshl_or_b32 v3, v4, 4, v3
    s_lshl_b32 s24, s20, 14
    s_lshl_b32 s25, s21, 10
    s_add_u32 s24, s24, s25
    s_lshl_b32 s25, s22, 6
    s_add_u32 s24, s24, s25
    s_add_u32 s25, s24, 8192
    s_add_u32 s27, s26, 1024
    s_mov_b32 s14, 0x200000
    s_mov_b32 s15, 0x20000
    s_mov_b32 m0, s26
    s_cmp_eq_u32 s23, 0
    s_waitcnt lgkmcnt(0)
    s_cselect_b32 s12, s4, s6
    s_cselect_b32 s13, s5, s7
    buffer_load_dwordx4 v3, s[12:15], s24 offen  lds
    s_mov_b32 m0, s27
    s_nop 0
    buffer_load_dwordx4 v3, s[12:15], s25 offen  lds

    s_mov_b32 s16, s8
    s_mov_b32 s17, s9
    s_mov_b32 s18, 0x409000
    s_mov_b32 s19, 0x20000
    s_lshl_b32 s93, s23, 8
    s_add_u32 s93, s93, 4227072
    buffer_load_dword v1, off, s[16:19], s93 sc1

    v_lshrrev_b32 v80, 5, v2
    v_and_b32 v81, 31, v2
    v_bfe_u32 v4, v81, 1, 3
    v_and_b32 v5, 1, v81
    v_and_b32 v6, 15, v81
    v_cmp_eq_u32 vcc, 1, v6
    v_cvt_f32_u32 v7, v4
    v_cvt_f32_u32 v64, v5
    v_mul_f32 v7, 0x3d800000, v7
    v_mul_f32 v64, 0x3e800000, v64
    v_cndmask_b32 v7, v7, 0.5, vcc
    v_cndmask_b32 v64, v64, 0, vcc
    v_lshlrev_b32 v65, 3, v80
    v_cvt_f32_u32 v65, v65
    v_fma_f32 v64, v65, v7, v64

    v_cos_f32 v66, v64
    v_add_f32 v65, v64, v7
    v_cos_f32 v74, v7
    v_cos_f32 v67, v65
    s_nop 0
    v_add_f32 v74, v74, v74

    v_fma_f32 v68, v74, v67, -v66
    v_fma_f32 v69, v74, v68, -v67
    v_cvt_pk_bf16_f32 v104, v66, v67
    v_fma_f32 v70, v74, v69, -v68
    v_fma_f32 v71, v74, v70, -v69
    v_cvt_pk_bf16_f32 v105, v68, v69
    v_fma_f32 v72, v74, v71, -v70
    v_fma_f32 v73, v74, v72, -v71
    v_cvt_pk_bf16_f32 v106, v70, v71
    v_cvt_pk_bf16_f32 v107, v72, v73
    v_lshrrev_b32 v4, 4, v81
    v_and_b32 v5, 7, v81
    v_lshl_or_b32 v4, v4, 3, v5
    v_bfe_u32 v5, v81, 3, 1
    v_cvt_f32_u32 v6, v5
    v_mul_f32 v6, 0x3e800000, v6
    s_cmp_eq_u32 s20, 0
    s_cbranch_scc1 P1_SPECIAL
    v_lshlrev_b32 v7, 4, v4
    v_add_u32 v7, s20, v7
    v_mov_b32 v64, v6
    v_add_f32 v65, 0xbe800000, v6
    v_mov_b32 v66, -1
    s_branch P1_COMMON
P1_SPECIAL:
    v_lshlrev_b32 v7, 4, v4
    v_cmp_le_u32 vcc, 8, v4
    v_subrev_u32 v67, 120, v7
    v_mov_b32 v66, 0xffff
    v_mov_b32 v68, 0xffff0000
    v_cndmask_b32 v7, v7, v67, vcc
    v_cndmask_b32 v66, v66, v68, vcc
    v_cmp_eq_u32 vcc, 8, v81
    v_mov_b32 v67, 0x80
    v_mov_b32 v64, v6
    v_cndmask_b32 v7, v7, v67, vcc
    v_cndmask_b32 v64, v64, 0, vcc
    s_nop 0
    v_mov_b32 v65, v64
P1_COMMON:
    v_cvt_f32_u32 v7, v7
    v_lshlrev_b32 v67, 2, v80
    v_cvt_f32_u32 v67, v67
    v_mul_f32 v7, 0x3b800000, v7
    v_fma_f32 v64, v67, v7, v64
    v_fma_f32 v65, v67, v7, v65

    v_cos_f32 v72, v64
    v_cos_f32 v73, v65
    v_add_f32 v64, v64, v7
    v_add_f32 v65, v65, v7
    v_cos_f32 v78, v7
    v_cos_f32 v74, v64
    v_cos_f32 v75, v65

    v_cvt_pk_bf16_f32 v108, v72, v73
    v_add_f32 v78, v78, v78
    v_cvt_pk_bf16_f32 v109, v74, v75
    v_pk_fma_f32 v[76:77], v[74:75], v[78:79], v[72:73] op_sel_hi:[1,0,1] neg_lo:[0,0,1] neg_hi:[0,0,1]
    v_cvt_pk_bf16_f32 v110, v76, v77
    v_pk_fma_f32 v[72:73], v[76:77], v[78:79], v[74:75] op_sel_hi:[1,0,1] neg_lo:[0,0,1] neg_hi:[0,0,1]
    v_cvt_pk_bf16_f32 v111, v72, v73
    v_pk_fma_f32 v[74:75], v[72:73], v[78:79], v[76:77] op_sel_hi:[1,0,1] neg_lo:[0,0,1] neg_hi:[0,0,1]
    v_pk_fma_f32 v[76:77], v[74:75], v[78:79], v[72:73] op_sel_hi:[1,0,1] neg_lo:[0,0,1] neg_hi:[0,0,1]
    v_pk_fma_f32 v[72:73], v[76:77], v[78:79], v[74:75] op_sel_hi:[1,0,1] neg_lo:[0,0,1] neg_hi:[0,0,1]
    v_pk_fma_f32 v[74:75], v[72:73], v[78:79], v[76:77] op_sel_hi:[1,0,1] neg_lo:[0,0,1] neg_hi:[0,0,1]
    v_pk_fma_f32 v[76:77], v[74:75], v[78:79], v[72:73] op_sel_hi:[1,0,1] neg_lo:[0,0,1] neg_hi:[0,0,1]
    v_cvt_pk_bf16_f32 v112, v76, v77
    v_pk_fma_f32 v[72:73], v[76:77], v[78:79], v[74:75] op_sel_hi:[1,0,1] neg_lo:[0,0,1] neg_hi:[0,0,1]
    v_cvt_pk_bf16_f32 v113, v72, v73
    v_pk_fma_f32 v[74:75], v[72:73], v[78:79], v[76:77] op_sel_hi:[1,0,1] neg_lo:[0,0,1] neg_hi:[0,0,1]
    v_cvt_pk_bf16_f32 v114, v74, v75
    v_pk_fma_f32 v[76:77], v[74:75], v[78:79], v[72:73] op_sel_hi:[1,0,1] neg_lo:[0,0,1] neg_hi:[0,0,1]
    v_cvt_pk_bf16_f32 v115, v76, v77
    s_cmp_eq_u32 s20, 0
    s_cbranch_scc0 P1_NOMASK
    v_and_b32 v108, v108, v66
    v_and_b32 v109, v109, v66
    v_and_b32 v110, v110, v66
    v_and_b32 v111, v111, v66
    v_and_b32 v112, v112, v66
    v_and_b32 v113, v113, v66
    v_and_b32 v114, v114, v66
    v_and_b32 v115, v115, v66
P1_NOMASK:
    v_bfe_u32 v4, v2, 2, 2
    v_lshl_or_b32 v4, v80, 3, v4
    v_lshlrev_b32 v4, 6, v4
    v_bfe_u32 v5, v2, 4, 1
    v_lshl_or_b32 v4, v5, 5, v4
    v_and_b32 v5, 3, v2
    v_lshl_or_b32 v4, v5, 3, v4
    v_add_u32 v124, s26, v4
    s_lshl_b32 s28, s20, 8
    s_add_u32 s28, s28, 16384
    v_lshlrev_b32 v4, 3, v81
    v_lshl_or_b32 v5, v80, 12, v4
    v_add_u32 v125, s28, v5
    s_add_u32 s28, s26, 16384
    v_lshl_or_b32 v5, v80, 9, v4
    v_add_u32 v126, s28, v5
    v_and_b32 v4, 7, v2
    v_lshlrev_b32 v4, 14, v4
    v_bfe_u32 v5, v2, 3, 1
    v_lshl_or_b32 v4, v5, 6, v4
    v_bfe_u32 v5, v2, 4, 1
    v_lshl_or_b32 v4, v5, 5, v4
    v_lshl_or_b32 v127, v80, 4, v4
    s_lshl_b32 s28, s23, 21
    s_lshl_b32 s29, s20, 18
    s_add_u32 s28, s28, s29
    s_lshl_b32 s29, s21, 11
    s_add_u32 s28, s28, s29
    s_lshl_b32 s29, s22, 7
    s_add_u32 s28, s28, s29
    s_add_u32 s29, s28, 0x20000

    v_lshlrev_b32 v0, 4, v2
    v_and_b32 v99, 15, v2
    v_lshrrev_b32 v100, 4, v2
    v_add_u32 v0, 32768, v0
    v_cvt_f32_u32 v99, v99
    s_cmp_ge_u32 s20, 4
    s_cbranch_scc1 SH_W4
    s_lshl_b32 s40, s20, 3
    s_lshr_b32 s41, s20, 1
    v_lshl_add_u32 v100, v100, 1, s40
    v_mul_f32 v96, 0x3d000000, v99
    v_cvt_f32_u32 v100, v100
    s_lshl_b32 s41, s41, 10
    s_and_b32 s42, s20, 1
    v_mul_f32 v97, v100, v96
    s_lshl_b32 s42, s42, 3
    s_add_u32 s41, s41, s42
    v_add_f32 v99, v97, v96
    v_cos_f32 v100, v97
    v_cos_f32 v101, v99
    v_sin_f32 v102, v97
    v_sin_f32 v103, v99
    v_add_u32 v98, s41, v0
    v_cvt_pk_bf16_f32 v88, v100, v101
    v_cvt_pk_bf16_f32 v91, v100, v101
    v_cvt_pk_bf16_f32 v92, v100, -v101
    v_cvt_pk_bf16_f32 v95, v100, -v101
    v_cvt_pk_bf16_f32 v89, v102, v103
    v_cvt_pk_bf16_f32 v90, -v102, -v103
    v_cvt_pk_bf16_f32 v93, v102, -v103
    v_cvt_pk_bf16_f32 v94, -v102, v103
    ds_write_b64 v98, v[88:89] offset:0
    ds_write_b64 v98, v[90:91] offset:2048
    ds_write_b64 v98, v[92:93] offset:4096
    ds_write_b64 v98, v[94:95] offset:6144
    s_branch SH_DONE
SH_W4:
    v_cvt_f32_u32 v100, v100
    s_cmp_ge_u32 s20, 6
    v_mul_f32 v89, 4.0, v100
    s_cbranch_scc1 SH_W6
    s_and_b32 s40, s20, 1
    s_mul_i32 s41, s40, 0x3d000000
    s_lshl_b32 s40, s40, 10
    v_mul_f32 v87, 0x3b000000, v99
    v_add_u32 v98, s40, v0
    v_add_f32 v87, s41, v87
    v_mul_f32 v88, v89, v87

    v_cos_f32 v92, v88
    v_sin_f32 v100, v88
    v_add_f32 v88, v88, v87
    v_cos_f32 v93, v88
    v_sin_f32 v101, v88
    v_add_f32 v88, v88, v87
    v_cos_f32 v94, v88
    v_sin_f32 v102, v88
    v_add_f32 v88, v88, v87
    v_cos_f32 v95, v88
    v_sin_f32 v103, v88
    s_nop 0
    ds_write_b128 v98, v[92:95] offset:8192
    ds_write_b128 v98, v[100:103] offset:10240
    s_branch SH_DONE
SH_W6:
    s_cmp_eq_u32 s20, 6
    s_cbranch_scc0 SH_DONE
    v_mul_f32 v87, 0x3d800000, v99
    v_mul_f32 v88, v89, v87

    v_cos_f32 v90, v88
    v_sin_f32 v94, v88
    v_add_f32 v88, v88, v87
    v_cos_f32 v91, v88
    v_sin_f32 v95, v88
    v_add_f32 v88, v88, v87
    v_cos_f32 v92, v88
    v_sin_f32 v96, v88
    v_add_f32 v88, v88, v87
    v_cos_f32 v93, v88
    v_sin_f32 v97, v88
    s_nop 0
    v_cvt_pk_bf16_f32 v100, v90, v91
    v_cvt_pk_bf16_f32 v101, v92, v93
    v_cvt_pk_bf16_f32 v102, v94, v95
    v_cvt_pk_bf16_f32 v103, v96, v97
    v_cvt_pk_bf16_f32 v88, -v94, -v95
    v_cvt_pk_bf16_f32 v89, -v96, -v97
    v_cvt_pk_bf16_f32 v90, v90, v91
    v_cvt_pk_bf16_f32 v91, v92, v93
    ds_write_b128 v0, v[100:103] offset:12288
    ds_write_b128 v0, v[88:91] offset:13312
SH_DONE:

    s_waitcnt vmcnt(2)
    ds_read_b64_tr_b16 v[116:117], v124 offset:0
    ds_read_b64_tr_b16 v[118:119], v124 offset:256
    s_waitcnt vmcnt(1)
    ds_read_b64_tr_b16 v[120:121], v124 offset:1024
    ds_read_b64_tr_b16 v[122:123], v124 offset:1280
    s_waitcnt lgkmcnt(2)
    v_mfma_f32_32x32x16_bf16 v[64:79], v[104:107], v[116:119], 0
    s_waitcnt lgkmcnt(0)
    v_mfma_f32_32x32x16_bf16 v[88:103], v[104:107], v[120:123], 0
    s_nop 10

    v_cvt_pk_bf16_f32 v116, v64, v65
    v_cvt_pk_bf16_f32 v117, v88, v89
    ds_write_b64 v125, v[116:117] offset:0
    v_cvt_pk_bf16_f32 v118, v66, v67
    v_cvt_pk_bf16_f32 v119, v90, v91
    ds_write_b64 v125, v[118:119] offset:2048
    v_cvt_pk_bf16_f32 v120, v68, v69
    v_cvt_pk_bf16_f32 v121, v92, v93
    ds_write_b64 v125, v[120:121] offset:8192
    v_cvt_pk_bf16_f32 v122, v70, v71
    v_cvt_pk_bf16_f32 v123, v94, v95
    ds_write_b64 v125, v[122:123] offset:10240
    s_waitcnt vmcnt(0) lgkmcnt(0)
    s_barrier
    ds_read_b64 v[116:117], v126 offset:0
    ds_read_b64 v[118:119], v126 offset:256
    ds_read_b64 v[120:121], v126 offset:1024
    ds_read_b64 v[122:123], v126 offset:1280
    s_waitcnt lgkmcnt(2)
    v_mfma_f32_32x32x16_bf16 v[64:79], v[116:119], v[108:111], 0
    s_waitcnt lgkmcnt(0)
    v_mfma_f32_32x32x16_bf16 v[64:79], v[120:123], v[112:115], v[64:79]
    s_nop 10

    v_cvt_pk_bf16_f32 v116, v64, v65
    v_cvt_pk_bf16_f32 v117, v66, v67
    v_cvt_pk_bf16_f32 v118, v68, v69
    v_cvt_pk_bf16_f32 v119, v70, v71
    v_cvt_pk_bf16_f32 v120, v72, v73
    v_cvt_pk_bf16_f32 v121, v74, v75
    v_cvt_pk_bf16_f32 v122, v76, v77
    v_cvt_pk_bf16_f32 v123, v78, v79
    s_nop 1
    v_permlane32_swap_b32 v116, v118
    v_permlane32_swap_b32 v117, v119
    v_permlane32_swap_b32 v120, v122
    v_permlane32_swap_b32 v121, v123
    s_nop 1
    v_permlane16_swap_b32 v116, v120
    v_permlane16_swap_b32 v117, v121
    v_permlane16_swap_b32 v118, v122
    v_permlane16_swap_b32 v119, v123
    buffer_store_dwordx4 v[116:119], v127, s[16:19], s28 offen sc1
    buffer_store_dwordx4 v[120:123], v127, s[16:19], s29 offen sc1

    s_mov_b32 s12, s56
    s_mov_b32 s13, s57
    s_mov_b32 s14, 0x400000
    s_mov_b32 s15, 0x20000
    s_lshr_b32 s30, s2, 7
    s_lshl_b32 s31, s21, 4
    s_or_b32 s31, s31, s22
    s_and_b32 s32, s31, 127
    s_lshr_b32 s34, s32, 4
    s_and_b32 s35, s32, 15
    s_lshl_b32 s36, s35, 4
    s_add_u32 s33, s36, s34
    s_sub_u32 s37, s36, 120
    s_cmp_ge_u32 s35, 8
    s_cselect_b32 s37, s37, s36
    s_cmp_eq_u32 s34, 0
    s_cselect_b32 s33, s37, s33
    s_cmp_eq_u32 s31, 128
    s_cselect_b32 s33, 128, s33

    v_and_b32 v4, 15, v2
    v_lshrrev_b32 v5, 4, v2
    v_lshlrev_b32 v6, 3, v2
    ds_read_b128 v[8:11], v0 offset:0
    v_add_u32 v80, s26, v6
    s_add_u32 s40, s26, 16384
    v_lshlrev_b32 v6, 2, v4
    v_lshl_or_b32 v6, v5, 9, v6
    ds_read_b128 v[12:15], v0 offset:1024
    v_add_u32 v81, s40, v6
    v_and_b32 v6, 31, v2
    v_lshrrev_b32 v7, 5, v2
    ds_read_b128 v[16:19], v0 offset:2048
    s_and_b32 s43, s20, 3
    s_lshr_b32 s44, s20, 2
    s_lshl_b32 s45, s43, 7
    v_add_u32 v87, s45, v6
    v_lshlrev_b32 v88, 13, v7
    v_add_u32 v88, 16384, v88
    ds_read_b128 v[20:23], v0 offset:3072
    s_cmp_eq_u32 s44, 0
    s_cselect_b32 s46, 0, -1
    s_cselect_b32 s47, 0, 1

    v_xor_b32 v89, s46, v87
    v_add_u32 v89, s47, v89
    v_and_b32 v89, 0x1ff, v89
    ds_read_b128 v[24:27], v0 offset:4096
    v_lshl_add_u32 v82, v89, 2, v88

    v_add_u32 v87, 32, v87
    v_xor_b32 v89, s46, v87
    ds_read_b128 v[28:31], v0 offset:5120
    v_add_u32 v89, s47, v89
    v_and_b32 v89, 0x1ff, v89
    v_lshl_add_u32 v83, v89, 2, v88
    ds_read_b128 v[32:35], v0 offset:6144

    v_add_u32 v87, 32, v87
    v_xor_b32 v89, s46, v87
    v_add_u32 v89, s47, v89
    ds_read_b128 v[36:39], v0 offset:7168
    v_and_b32 v89, 0x1ff, v89
    v_lshl_add_u32 v84, v89, 2, v88

    v_add_u32 v87, 32, v87
    ds_read_b128 v[40:43], v0 offset:8192
    v_xor_b32 v89, s46, v87
    v_add_u32 v89, s47, v89
    v_and_b32 v89, 0x1ff, v89
    ds_read_b128 v[44:47], v0 offset:9216
    v_lshl_add_u32 v85, v89, 2, v88

    v_and_b32 v89, 7, v6
    v_lshlrev_b32 v89, 8, v89
    ds_read_b128 v[48:51], v0 offset:10240
    v_add_u32 v89, s33, v89
    v_xor_b32 v89, s46, v89
    v_add_u32 v89, s47, v89
    ds_read_b128 v[52:55], v0 offset:11264
    v_and_b32 v89, 0x7ff, v89
    v_lshlrev_b32 v89, 11, v89
    v_bfe_u32 v90, v2, 3, 1
    ds_read_b128 v[56:59], v0 offset:12288
    v_lshl_or_b32 v89, v90, 6, v89
    v_bfe_u32 v90, v2, 4, 1
    v_lshl_or_b32 v89, v90, 5, v89
    ds_read_b128 v[60:63], v0 offset:13312
    v_lshl_or_b32 v86, v7, 4, v89
    s_lshl_b32 s56, s30, 10
    s_lshl_b32 s57, s43, 8
    s_add_u32 s56, s56, s57
    s_add_u32 s57, s56, 128

    v_lshlrev_b32 v3, 4, v2
    s_lshl_b32 s38, s30, 21
    s_lshl_b32 s39, s32, 14
    s_add_u32 s38, s38, s39
    s_add_u32 s38, s38, s26
    s_add_u32 s39, s38, 1024
    s_add_u32 s27, s26, 1024
    s_cmp_eq_u32 s32, 0
    s_cbranch_scc1 P2_SPEC_OOL
P2_SPEC_RET:

    s_lshl_b32 s66, s30, 14
    s_add_u32 s66, s66, 0x400000
    s_lshl_b32 s64, s34, 11
    s_lshl_b32 s65, s20, 8
    s_add_u32 s67, s66, s64
    s_add_u32 s67, s67, s65
    v_lshlrev_b32 v6, 2, v2

    s_lshl_b32 s64, s21, 8
    s_lshl_b32 s65, s22, 2
    s_add_u32 s64, s64, s65
    s_add_u32 s64, s64, s26
    s_add_u32 s92, s64, s66
    s_mov_b32 s65, 0x40000
    s_waitcnt vmcnt(0)
    v_add_u32 v1, 0x9e3779b9, v1
    s_mov_b64 exec, 1
    buffer_atomic_swap v1, off, s[16:19], s92 sc1
    s_mov_b64 exec, -1
    v_and_b32 v87, 31, v2
    v_lshrrev_b32 v88, 5, v2
    v_and_b32 v89, 7, v87
    v_lshlrev_b32 v89, 8, v89
    v_add_u32 v89, s33, v89
    v_cvt_f32_u32 v90, v89
    v_mul_f32 v90, 0x3a000000, v90
    v_lshlrev_b32 v91, 2, v88
    v_cvt_f32_u32 v91, v91
    v_lshrrev_b32 v92, 3, v87
    v_mul_f32 v91, v91, v90
    v_cmp_eq_u32 s[48:49], 0, v92
    v_cmp_eq_u32 s[50:51], 1, v92
    v_cmp_eq_u32 s[52:53], 2, v92
    v_cmp_eq_u32 s[54:55], 3, v92

    v_cos_f32 v93, v91
    v_sin_f32 v94, v91
    v_add_f32 v91, v91, v90
    v_cvt_pk_bf16_f32 v95, v93, v94
    v_cndmask_b32 v64, 0, v95, s[48:49]
    v_cndmask_b32 v68, 0, v95, s[50:51]
    v_cndmask_b32 v72, 0, v95, s[52:53]
    v_cndmask_b32 v76, 0, v95, s[54:55]
    v_cos_f32 v93, v91
    v_sin_f32 v94, v91
    v_add_f32 v91, v91, v90
    v_cvt_pk_bf16_f32 v95, v93, v94
    v_cndmask_b32 v65, 0, v95, s[48:49]
    v_cndmask_b32 v69, 0, v95, s[50:51]
    v_cndmask_b32 v73, 0, v95, s[52:53]
    v_cndmask_b32 v77, 0, v95, s[54:55]
    v_cos_f32 v93, v91
    v_sin_f32 v94, v91
    v_add_f32 v91, v91, v90
    v_cvt_pk_bf16_f32 v95, v93, v94
    v_cndmask_b32 v66, 0, v95, s[48:49]
    v_cndmask_b32 v70, 0, v95, s[50:51]
    v_cndmask_b32 v74, 0, v95, s[52:53]
    v_cndmask_b32 v78, 0, v95, s[54:55]
    v_cos_f32 v93, v91
    v_sin_f32 v94, v91
    s_nop 0
    v_cvt_pk_bf16_f32 v95, v93, v94
    v_cndmask_b32 v67, 0, v95, s[48:49]
    v_cndmask_b32 v71, 0, v95, s[50:51]
    v_cndmask_b32 v75, 0, v95, s[52:53]
    v_cndmask_b32 v79, 0, v95, s[54:55]
POLL_PRE:
    s_mov_b32 m0, s26
    s_mov_b64 exec, 0xffff
POLL:
    buffer_load_dword v88, v6, s[16:19], s67 offen sc1
    s_sub_u32 s65, s65, 1
    s_cbranch_scc1 POLL_OUT
    s_waitcnt vmcnt(0)
    v_cmp_ne_u32 vcc, v88, v1
    s_cbranch_vccnz POLL
POLL_OUT:
    s_mov_b64 exec, -1

    buffer_load_dwordx4 v3, s[16:19], s38 offen sc1 lds
    s_mov_b32 m0, s27
    s_nop 0
    buffer_load_dwordx4 v3, s[16:19], s39 offen sc1 lds

    s_waitcnt vmcnt(1)
    ds_read_b64_tr_b16 v[88:89], v80 offset:0
    ds_read_b64_tr_b16 v[90:91], v80 offset:512
    s_waitcnt vmcnt(0)
    ds_read_b64_tr_b16 v[92:93], v80 offset:1024
    ds_read_b64_tr_b16 v[94:95], v80 offset:1536
    s_waitcnt lgkmcnt(2)
    v_mfma_f32_16x16x32_bf16 v[96:99], v[88:91], v[8:11], 0
    v_mfma_f32_16x16x32_bf16 v[100:103], v[88:91], v[16:19], 0
    v_mfma_f32_16x16x32_bf16 v[104:107], v[88:91], v[24:27], 0
    v_mfma_f32_16x16x32_bf16 v[108:111], v[88:91], v[32:35], 0
    s_waitcnt lgkmcnt(0)
    v_mfma_f32_16x16x32_bf16 v[96:99], v[92:95], v[12:15], v[96:99]
    v_mfma_f32_16x16x32_bf16 v[100:103], v[92:95], v[20:23], v[100:103]
    v_mfma_f32_16x16x32_bf16 v[104:107], v[92:95], v[28:31], v[104:107]
    v_mfma_f32_16x16x32_bf16 v[108:111], v[92:95], v[36:39], v[108:111]
    s_nop 5
    v_pk_mul_f32 v[88:89], v[96:97], v[40:41]
    v_pk_mul_f32 v[90:91], v[100:101], v[40:41]
    v_pk_fma_f32 v[88:89], v[100:101], v[48:49], v[88:89]
    v_pk_fma_f32 v[90:91], v[96:97], v[48:49], v[90:91] neg_lo:[1,0,0] neg_hi:[1,0,0]
    v_pk_mul_f32 v[92:93], v[98:99], v[42:43]
    v_pk_mul_f32 v[94:95], v[102:103], v[42:43]
    v_pk_fma_f32 v[92:93], v[102:103], v[50:51], v[92:93]
    v_pk_fma_f32 v[94:95], v[98:99], v[50:51], v[94:95] neg_lo:[1,0,0] neg_hi:[1,0,0]
    v_cvt_pk_bf16_f32 v112, v88, v89
    v_cvt_pk_bf16_f32 v114, v90, v91
    v_cvt_pk_bf16_f32 v113, v92, v93
    v_cvt_pk_bf16_f32 v115, v94, v95
    v_pk_mul_f32 v[88:89], v[104:105], v[44:45]
    v_pk_mul_f32 v[90:91], v[108:109], v[44:45]
    v_pk_fma_f32 v[88:89], v[108:109], v[52:53], v[88:89]
    v_pk_fma_f32 v[90:91], v[104:105], v[52:53], v[90:91] neg_lo:[1,0,0] neg_hi:[1,0,0]
    v_pk_mul_f32 v[92:93], v[106:107], v[46:47]
    v_pk_mul_f32 v[94:95], v[110:111], v[46:47]
    v_pk_fma_f32 v[92:93], v[110:111], v[54:55], v[92:93]
    v_pk_fma_f32 v[94:95], v[106:107], v[54:55], v[94:95] neg_lo:[1,0,0] neg_hi:[1,0,0]
    v_cvt_pk_bf16_f32 v116, v88, v89
    v_cvt_pk_bf16_f32 v118, v90, v91
    v_cvt_pk_bf16_f32 v117, v92, v93
    v_cvt_pk_bf16_f32 v119, v94, v95
    s_nop 1
    v_mfma_f32_16x16x32_bf16 v[96:99], v[56:59], v[112:115], 0
    v_mfma_f32_16x16x32_bf16 v[100:103], v[60:63], v[112:115], 0
    v_mfma_f32_16x16x32_bf16 v[104:107], v[56:59], v[116:119], 0
    v_mfma_f32_16x16x32_bf16 v[108:111], v[60:63], v[116:119], 0
    s_nop 7
    v_cvt_pk_bf16_f32 v120, v96, v100
    v_cvt_pk_bf16_f32 v121, v104, v108
    ds_write2_b32 v81, v120, v121 offset0:0 offset1:16
    v_cvt_pk_bf16_f32 v122, v97, v101
    v_cvt_pk_bf16_f32 v123, v105, v109
    ds_write2_b32 v81, v122, v123 offset0:32 offset1:48
    v_cvt_pk_bf16_f32 v124, v98, v102
    v_cvt_pk_bf16_f32 v125, v106, v110
    ds_write2_b32 v81, v124, v125 offset0:64 offset1:80
    v_cvt_pk_bf16_f32 v126, v99, v103
    v_cvt_pk_bf16_f32 v127, v107, v111
    ds_write2_b32 v81, v126, v127 offset0:96 offset1:112
    s_waitcnt lgkmcnt(0)
    s_barrier
    s_cmp_ge_u32 s2, 256
    s_cbranch_scc1 EPOCH_OOL
EPOCH_RET:

    s_and_b32 s58, s32, 127
    s_cmp_eq_u32 s58, 0
    s_cselect_b32 s58, s44, 0
    s_cmp_lg_u32 s58, 0
    s_cbranch_scc1 P2_END
    ds_read2st64_b32 v[96:97], v82 offset0:0 offset1:8
    ds_read2st64_b32 v[98:99], v82 offset0:16 offset1:24
    ds_read2st64_b32 v[100:101], v83 offset0:0 offset1:8
    ds_read2st64_b32 v[102:103], v83 offset0:16 offset1:24
    ds_read2st64_b32 v[104:105], v84 offset0:0 offset1:8
    ds_read2st64_b32 v[106:107], v84 offset0:16 offset1:24
    ds_read2st64_b32 v[108:109], v85 offset0:0 offset1:8
    ds_read2st64_b32 v[110:111], v85 offset0:16 offset1:24
    s_waitcnt lgkmcnt(6)
    v_mfma_f32_32x32x16_bf16 v[112:127], v[96:99], v[64:67], 0
    s_waitcnt lgkmcnt(4)
    v_mfma_f32_32x32x16_bf16 v[112:127], v[100:103], v[68:71], v[112:127]
    s_waitcnt lgkmcnt(2)
    v_mfma_f32_32x32x16_bf16 v[112:127], v[104:107], v[72:75], v[112:127]
    s_waitcnt lgkmcnt(0)
    v_mfma_f32_32x32x16_bf16 v[112:127], v[108:111], v[76:79], v[112:127]
    s_nop 11
    v_cvt_pk_bf16_f32 v88, v112, v113
    v_cvt_pk_bf16_f32 v89, v114, v115
    v_cvt_pk_bf16_f32 v90, v116, v117
    v_cvt_pk_bf16_f32 v91, v118, v119
    v_cvt_pk_bf16_f32 v92, v120, v121
    v_cvt_pk_bf16_f32 v93, v122, v123
    v_cvt_pk_bf16_f32 v94, v124, v125
    v_cvt_pk_bf16_f32 v95, v126, v127
    s_nop 1
    v_permlane32_swap_b32 v88, v90
    v_permlane32_swap_b32 v89, v91
    v_permlane32_swap_b32 v92, v94
    v_permlane32_swap_b32 v93, v95
    s_nop 1
    v_permlane16_swap_b32 v88, v92
    v_permlane16_swap_b32 v89, v93
    v_permlane16_swap_b32 v90, v94
    v_permlane16_swap_b32 v91, v95
    buffer_store_dwordx4 v[88:91], v86, s[12:15], s56 offen sc1
    buffer_store_dwordx4 v[92:95], v86, s[12:15], s57 offen sc1
P2_END:

K_END:
    s_endpgm
P2_SPEC_OOL:
    v_bfe_u32 v4, v2, 2, 1
    s_lshr_b32 s40, s31, 1
    v_lshlrev_b32 v4, 30, v4
    v_add_u32 v3, s40, v3
    v_add_u32 v3, v4, v3
    s_branch P2_SPEC_RET

POLL_SPECIAL:
    s_lshl_b32 s66, s30, 14
    s_add_u32 s66, s66, 0x400000
    s_lshl_b32 s64, s34, 11
    s_lshl_b32 s65, s20, 8
    s_add_u32 s67, s66, s64
    s_add_u32 s67, s67, s65
    v_lshlrev_b32 v6, 2, v2

    s_mov_b32 s65, 0x40000
    s_waitcnt vmcnt(0)
    v_add_u32 v1, 0x9e3779b9, v1
    s_branch POLL_PRE

EPOCH_OOL:
    s_cmp_eq_u32 s20, 0
    s_cbranch_scc0 EPOCH_RET
    s_mov_b64 exec, 1
    s_lshl_b32 s64, s30, 8
    s_add_u32 s64, s64, 4227072
    buffer_store_dword v1, off, s[16:19], s64 sc1
    s_mov_b64 exec, -1
    s_branch EPOCH_RET

SPECIAL_WG:
    s_waitcnt lgkmcnt(0)
    s_mov_b32 s16, s8
    s_mov_b32 s17, s9
    s_mov_b32 s18, 0x409000
    s_mov_b32 s19, 0x20000
    s_and_b32 s93, s2, 1
    s_lshl_b32 s93, s93, 8
    s_add_u32 s93, s93, 4227072
    buffer_load_dword v1, off, s[16:19], s93 sc1

    v_lshlrev_b32 v0, 4, v2
    v_and_b32 v99, 15, v2
    v_lshrrev_b32 v100, 4, v2
    v_add_u32 v0, 32768, v0
    v_cvt_f32_u32 v99, v99
    s_cmp_ge_u32 s20, 4
    s_cbranch_scc1 SH_W4B
    s_lshl_b32 s40, s20, 3
    s_lshr_b32 s41, s20, 1
    v_lshl_add_u32 v100, v100, 1, s40
    v_mul_f32 v96, 0x3d000000, v99
    v_cvt_f32_u32 v100, v100
    s_lshl_b32 s41, s41, 10
    s_and_b32 s42, s20, 1
    v_mul_f32 v97, v100, v96
    s_lshl_b32 s42, s42, 3
    s_add_u32 s41, s41, s42
    v_add_f32 v99, v97, v96
    v_cos_f32 v100, v97
    v_cos_f32 v101, v99
    v_sin_f32 v102, v97
    v_sin_f32 v103, v99
    v_add_u32 v98, s41, v0
    v_cvt_pk_bf16_f32 v88, v100, v101
    v_cvt_pk_bf16_f32 v91, v100, v101
    v_cvt_pk_bf16_f32 v92, v100, -v101
    v_cvt_pk_bf16_f32 v95, v100, -v101
    v_cvt_pk_bf16_f32 v89, v102, v103
    v_cvt_pk_bf16_f32 v90, -v102, -v103
    v_cvt_pk_bf16_f32 v93, v102, -v103
    v_cvt_pk_bf16_f32 v94, -v102, v103
    ds_write_b64 v98, v[88:89] offset:0
    ds_write_b64 v98, v[90:91] offset:2048
    ds_write_b64 v98, v[92:93] offset:4096
    ds_write_b64 v98, v[94:95] offset:6144
    s_branch SH_DONEB
SH_W4B:
    v_cvt_f32_u32 v100, v100
    s_cmp_ge_u32 s20, 6
    v_mul_f32 v89, 4.0, v100
    s_cbranch_scc1 SH_W6B
    s_and_b32 s40, s20, 1
    s_mul_i32 s41, s40, 0x3d000000
    s_lshl_b32 s40, s40, 10
    v_mul_f32 v87, 0x3b000000, v99
    v_add_u32 v98, s40, v0
    v_add_f32 v87, s41, v87
    v_mul_f32 v88, v89, v87

    v_cos_f32 v92, v88
    v_sin_f32 v100, v88
    v_add_f32 v88, v88, v87
    v_cos_f32 v93, v88
    v_sin_f32 v101, v88
    v_add_f32 v88, v88, v87
    v_cos_f32 v94, v88
    v_sin_f32 v102, v88
    v_add_f32 v88, v88, v87
    v_cos_f32 v95, v88
    v_sin_f32 v103, v88
    s_nop 0
    ds_write_b128 v98, v[92:95] offset:8192
    ds_write_b128 v98, v[100:103] offset:10240
    s_branch SH_DONEB
SH_W6B:
    s_cmp_eq_u32 s20, 6
    s_cbranch_scc0 SH_DONEB
    v_mul_f32 v87, 0x3d800000, v99
    v_mul_f32 v88, v89, v87

    v_cos_f32 v90, v88
    v_sin_f32 v94, v88
    v_add_f32 v88, v88, v87
    v_cos_f32 v91, v88
    v_sin_f32 v95, v88
    v_add_f32 v88, v88, v87
    v_cos_f32 v92, v88
    v_sin_f32 v96, v88
    v_add_f32 v88, v88, v87
    v_cos_f32 v93, v88
    v_sin_f32 v97, v88
    s_nop 0
    v_cvt_pk_bf16_f32 v100, v90, v91
    v_cvt_pk_bf16_f32 v101, v92, v93
    v_cvt_pk_bf16_f32 v102, v94, v95
    v_cvt_pk_bf16_f32 v103, v96, v97
    v_cvt_pk_bf16_f32 v88, -v94, -v95
    v_cvt_pk_bf16_f32 v89, -v96, -v97
    v_cvt_pk_bf16_f32 v90, v90, v91
    v_cvt_pk_bf16_f32 v91, v92, v93
    ds_write_b128 v0, v[100:103] offset:12288
    ds_write_b128 v0, v[88:91] offset:13312
SH_DONEB:

    s_waitcnt lgkmcnt(0)
    s_barrier
    ds_read_b128 v[8:11], v0 offset:0
    ds_read_b128 v[12:15], v0 offset:1024
    ds_read_b128 v[16:19], v0 offset:2048
    ds_read_b128 v[20:23], v0 offset:3072
    ds_read_b128 v[24:27], v0 offset:4096
    ds_read_b128 v[28:31], v0 offset:5120
    ds_read_b128 v[32:35], v0 offset:6144
    ds_read_b128 v[36:39], v0 offset:7168
    ds_read_b128 v[40:43], v0 offset:8192
    ds_read_b128 v[44:47], v0 offset:9216
    ds_read_b128 v[48:51], v0 offset:10240
    ds_read_b128 v[52:55], v0 offset:11264
    ds_read_b128 v[56:59], v0 offset:12288
    ds_read_b128 v[60:63], v0 offset:13312
    s_mov_b32 s12, s56
    s_mov_b32 s13, s57
    s_mov_b32 s14, 0x400000
    s_mov_b32 s15, 0x20000
    s_and_b32 s30, s2, 1
    s_movk_i32 s31, 128
    s_and_b32 s32, s31, 127
    s_lshr_b32 s34, s32, 4
    s_and_b32 s35, s32, 15
    s_lshl_b32 s36, s35, 4
    s_add_u32 s33, s36, s34
    s_sub_u32 s37, s36, 120
    s_cmp_ge_u32 s35, 8
    s_cselect_b32 s37, s37, s36
    s_cmp_eq_u32 s34, 0
    s_cselect_b32 s33, s37, s33
    s_cmp_eq_u32 s31, 128
    s_cselect_b32 s33, 128, s33

    v_and_b32 v4, 15, v2
    v_lshrrev_b32 v5, 4, v2
    v_lshlrev_b32 v6, 3, v2
    v_add_u32 v80, s26, v6
    s_add_u32 s40, s26, 16384
    v_lshlrev_b32 v6, 2, v4
    v_lshl_or_b32 v6, v5, 9, v6
    v_add_u32 v81, s40, v6
    v_and_b32 v6, 31, v2
    v_lshrrev_b32 v7, 5, v2
    s_and_b32 s43, s20, 3
    s_lshr_b32 s44, s20, 2
    s_lshl_b32 s45, s43, 7
    v_add_u32 v87, s45, v6
    v_lshlrev_b32 v88, 13, v7
    v_add_u32 v88, 16384, v88
    s_cmp_eq_u32 s44, 0
    s_cselect_b32 s46, 0, -1
    s_cselect_b32 s47, 0, 1

    v_xor_b32 v89, s46, v87
    v_add_u32 v89, s47, v89
    v_and_b32 v89, 0x1ff, v89
    v_lshl_add_u32 v82, v89, 2, v88

    v_add_u32 v87, 32, v87
    v_xor_b32 v89, s46, v87
    v_add_u32 v89, s47, v89
    v_and_b32 v89, 0x1ff, v89
    v_lshl_add_u32 v83, v89, 2, v88

    v_add_u32 v87, 32, v87
    v_xor_b32 v89, s46, v87
    v_add_u32 v89, s47, v89
    v_and_b32 v89, 0x1ff, v89
    v_lshl_add_u32 v84, v89, 2, v88

    v_add_u32 v87, 32, v87
    v_xor_b32 v89, s46, v87
    v_add_u32 v89, s47, v89
    v_and_b32 v89, 0x1ff, v89
    v_lshl_add_u32 v85, v89, 2, v88

    v_and_b32 v89, 7, v6
    v_lshlrev_b32 v89, 8, v89
    v_add_u32 v89, s33, v89
    v_cvt_f32_u32 v90, v89
    v_mul_f32 v90, 0x3a000000, v90
    v_lshlrev_b32 v91, 2, v7
    v_cvt_f32_u32 v91, v91
    v_mul_f32 v91, v91, v90
    v_lshrrev_b32 v92, 3, v6
    v_cmp_eq_u32 s[48:49], 0, v92
    v_cmp_eq_u32 s[50:51], 1, v92
    v_cmp_eq_u32 s[52:53], 2, v92
    v_cmp_eq_u32 s[54:55], 3, v92

    v_cos_f32 v93, v91
    v_sin_f32 v94, v91
    v_add_f32 v91, v91, v90
    v_cvt_pk_bf16_f32 v95, v93, v94
    v_cndmask_b32 v64, 0, v95, s[48:49]
    v_cndmask_b32 v68, 0, v95, s[50:51]
    v_cndmask_b32 v72, 0, v95, s[52:53]
    v_cndmask_b32 v76, 0, v95, s[54:55]
    v_cos_f32 v93, v91
    v_sin_f32 v94, v91
    v_add_f32 v91, v91, v90
    v_cvt_pk_bf16_f32 v95, v93, v94
    v_cndmask_b32 v65, 0, v95, s[48:49]
    v_cndmask_b32 v69, 0, v95, s[50:51]
    v_cndmask_b32 v73, 0, v95, s[52:53]
    v_cndmask_b32 v77, 0, v95, s[54:55]
    v_cos_f32 v93, v91
    v_sin_f32 v94, v91
    v_add_f32 v91, v91, v90
    v_cvt_pk_bf16_f32 v95, v93, v94
    v_cndmask_b32 v66, 0, v95, s[48:49]
    v_cndmask_b32 v70, 0, v95, s[50:51]
    v_cndmask_b32 v74, 0, v95, s[52:53]
    v_cndmask_b32 v78, 0, v95, s[54:55]
    v_cos_f32 v93, v91
    v_sin_f32 v94, v91
    s_nop 0
    v_cvt_pk_bf16_f32 v95, v93, v94
    v_cndmask_b32 v67, 0, v95, s[48:49]
    v_cndmask_b32 v71, 0, v95, s[50:51]
    v_cndmask_b32 v75, 0, v95, s[52:53]
    v_cndmask_b32 v79, 0, v95, s[54:55]
    v_xor_b32 v89, s46, v89
    v_add_u32 v89, s47, v89
    v_and_b32 v89, 0x7ff, v89
    v_lshlrev_b32 v89, 11, v89
    v_bfe_u32 v90, v2, 3, 1
    v_lshl_or_b32 v89, v90, 6, v89
    v_bfe_u32 v90, v2, 4, 1
    v_lshl_or_b32 v89, v90, 5, v89
    v_lshl_or_b32 v86, v7, 4, v89
    s_lshl_b32 s56, s30, 10
    s_lshl_b32 s57, s43, 8
    s_add_u32 s56, s56, s57
    s_add_u32 s57, s56, 128

    v_lshlrev_b32 v3, 4, v2
    s_lshl_b32 s38, s30, 21
    s_lshl_b32 s39, s32, 14
    s_add_u32 s38, s38, s39
    s_add_u32 s38, s38, s26
    s_add_u32 s39, s38, 1024
    s_add_u32 s27, s26, 1024
    s_cmp_eq_u32 s32, 0
    s_cbranch_scc0 P2_REGB
    v_bfe_u32 v4, v2, 2, 1
    s_lshr_b32 s40, s31, 1
    v_lshlrev_b32 v4, 30, v4
    v_add_u32 v3, s40, v3
    v_add_u32 v3, v4, v3
P2_REGB:

    s_branch POLL_SPECIAL
.section .rodata,"a"
.p2align 6
.amdhsa_kernel concat_heads__spectral_fnet__spectral_fnet__prompt_kernel
  .amdhsa_next_free_vgpr 128
  .amdhsa_next_free_sgpr 102
  .amdhsa_accum_offset 128
  .amdhsa_group_segment_fixed_size 0
  .amdhsa_kernarg_size 104
  .amdhsa_user_sgpr_count 2
  .amdhsa_user_sgpr_kernarg_segment_ptr 1
  .amdhsa_system_sgpr_workgroup_id_x 1
.end_amdhsa_kernel
```
